```python
import torch

def _softmax(x, axis=-1):
    return torch.softmax(x, dim=axis)
def _gelu(x):
    return torch.nn.functional.gelu(x, approximate="tanh")
def _silu(x):
    return torch.nn.functional.silu(x)
def _sigmoid(x):
    return torch.sigmoid(x)
def _layernorm(x, axis=-1, eps=1e-5):
    m = x.mean(dim=axis, keepdim=True)
    v = x.var(dim=axis, keepdim=True, unbiased=False)
    return (x - m) / torch.sqrt(v + eps)
def _scatter_add(tgt, idx, src, axis=0):
    return tgt.clone().index_add_(axis, idx, src)
def _segment_sum(src, seg, n):
    out = torch.zeros((n,) + src.shape[1:], dtype=src.dtype)
    return out.index_add_(0, seg, src)
def _pad(x, pw):
    flat = tuple(v for pair in reversed(pw) for v in pair)
    return torch.nn.functional.pad(x, flat)

kernel_name = 'standalone__rmsnorm__sampling'

def setup_inputs():

    _w = (lambda a: (lambda t: t.to(torch.bfloat16) if t.is_floating_point() else t)(torch.as_tensor(a)))
    B, S, D = 1024, 32, 512
    return {
        "x": _w((lambda *s: torch.randn(*s, dtype=torch.bfloat16) * 0.05)(B, S, D)),
        "g": _w((lambda *s: torch.randn(*s, dtype=torch.bfloat16) * 0.05)(D) + 1.0),
    }

def reference(x, g):
    rms = torch.sqrt((x * x).mean(axis=-1, keepdims=True) + 1e-6)
    return x / rms * g
```

```asm
; @launch grid=(256,1,1) block=(512,1,1) lds=0
.amdgcn_target "amdgcn-amd-amdhsa--gfx950"
.text
.globl standalone__rmsnorm__sampling_kernel
.p2align 8
.type standalone__rmsnorm__sampling_kernel,@function
standalone__rmsnorm__sampling_kernel:
    s_memrealtime s[40:41]
    s_load_dwordx2 s[12:13], s[0:1], 0
    s_load_dwordx2 s[16:17], s[0:1], 8
    s_load_dwordx2 s[28:29], s[0:1], 16
    s_load_dwordx2 s[10:11], s[0:1], 24
    s_cmp_ge_u32 s2, 256
    s_cbranch_scc1 L_done
    v_lshrrev_b32 v2, 6, v0
    v_lshlrev_b32 v1, 4, v0
    v_readfirstlane_b32 s3, v2
    v_and_b32 v1, 0x3f0, v1
    s_lshr_b32 s48, s2, 3
    s_and_b32 s22, s2, 3
    s_lshl2_add_u32 s21, s48, s22
    s_lshl_b32 s21, s21, 18
    s_lshr_b32 s23, s2, 2
    s_lshr_b32 s7, s3, 1
    s_xor_b32 s23, s23, s7
    s_and_b32 s23, s23, 1
    s_lshl_b32 s49, s23, 13
    s_or_b32 s49, s49, s21
    s_brev_b32 s44, s3
    s_lshr_b32 s44, s44, 19
    s_or_b32 s49, s49, s44
    v_add_u32 v44, s49, v1
    v_add_u32 v45, 16384, v44
    s_lshr_b32 s22, s21, 21
    s_xor_b32 s9, s22, s7
    s_mov_b32 s14, 0x2000000
    s_mov_b32 s15, 0x00020000
    s_mov_b32 s18, 1024
    s_mov_b32 s19, 0x00020000
    s_mov_b32 s30, s14
    s_mov_b32 s31, 0x00020000
    s_mov_b32 s20, 0xffff0000
    s_mov_b32 s6, 0
    s_mov_b32 s4, 4
    s_or_b32 s8, s2, s3
    s_getreg_b32 s27, hwreg(HW_REG_XCC_ID, 0, 3)
    s_lshl_b32 s45, s27, 4
    s_lshr_b32 s27, s27, 2
    s_xor_b32 s27, s27, s22
    s_xor_b32 s27, s27, s48
    s_and_b32 s46, s48, 1
    s_lshl_b32 s46, s46, 13
    s_lshl_b32 s47, s22, 21
    s_or_b32 s46, s46, s47
    s_mul_i32 s47, s2, 0x5bd1e995
    s_add_u32 s44, s45, s48
    v_mov_b32 v20, s44
    s_lshr_b32 s49, s48, 4
    s_or_b32 s36, s49, s3
    s_waitcnt lgkmcnt(0)
    s_cbranch_scc1 L_noprobe
    s_xor_b32 s42, s40, s47
    s_mul_i32 s42, s42, 0x9e3779b1
    s_lshr_b32 s42, s42, 11
    s_and_b32 s42, s42, 0x1fdf80
    s_or_b32 s46, s46, s42
    v_mov_b32 v16, s46
    v_xor_b32 v17, 0x2000, v16
    s_mov_b64 exec, 1
    buffer_load_dword v18, v16, s[12:15], 0 offen nt
    buffer_load_dword v19, v17, s[12:15], 0 offen nt
    global_load_ubyte v5, v20, s[10:11] sc1
    s_mov_b64 exec, -1
L_noprobe:
    s_barrier
    buffer_load_dwordx4 v[24:27], v44, s[12:15], 0 offen nt
    buffer_load_dwordx4 v[40:43], v1, s[16:19], 0 offen
    s_cmp_lg_u32 s36, 0
    s_cbranch_scc1 L_novote
    s_mov_b64 exec, 1
    s_waitcnt vmcnt(4)
    s_getreg_b32 s44, hwreg(HW_REG_IB_STS, 0, 4)
    s_cmp_le_u32 s44, 3
    s_addc_u32 s44, s27, 0
    s_and_b32 s44, s44, 1
    s_add_u32 s44, s44, 1
    v_mov_b32 v16, s44
    global_store_byte v20, v16, s[10:11]
    s_mov_b64 exec, -1
L_novote:
    s_barrier
    buffer_load_dwordx4 v[28:31], v45, s[12:15], 0 offen nt
    s_waitcnt vmcnt(1)
    v_lshlrev_b32 v8, 16, v40
    v_and_b32 v9, s20, v40
    v_lshlrev_b32 v10, 16, v41
    v_and_b32 v11, s20, v41
    v_lshlrev_b32 v12, 16, v42
    v_and_b32 v13, s20, v42
    v_lshlrev_b32 v14, 16, v43
    v_and_b32 v15, s20, v43
    s_mov_b32 s21, 0x3b003b00
    s_branch L_loop

L_choose:
    s_waitcnt vmcnt(2)
    s_load_dwordx4 s[40:43], s[10:11], s45
    s_and_b32 s44, s12, 0x1c1c00
    s_cbranch_scc1 L_fixed
    s_mov_b32 s49, 0
    s_mov_b32 s46, 0x01010101
    s_mov_b32 s47, s46
    s_waitcnt lgkmcnt(0)
    s_bcnt1_i32_b64 s26, s[40:41]
    s_bcnt1_i32_b64 s58, s[42:43]
    s_and_b64 s[40:41], s[40:41], s[46:47]
    s_and_b64 s[42:43], s[42:43], s[46:47]
    s_add_u32 s58, s58, s26
    s_bcnt1_i32_b64 s44, s[40:41]
    s_bcnt1_i32_b64 s26, s[42:43]
    s_add_u32 s44, s44, s26
    s_sub_u32 s58, s58, s44
    s_absdiff_i32 s59, s58, s44
    s_cmp_lt_u32 s59, 6
    s_cbranch_scc1 L_poll0
L_majority:
    s_cmp_gt_u32 s58, s44
    s_cselect_b32 s26, 2, 1
    s_cmp_eq_u32 s8, 0
    s_cbranch_scc1 L_publish
L_chosen:
    s_add_u32 s44, s26, s9
    s_andn2_b32 s44, 1, s44
    s_xor_b32 s44, s44, s23
    s_sub_u32 s49, s44, s23
    s_lshl_b32 s49, s49, 13
    s_add_u32 s38, s38, s49
    s_mov_b32 s6, 1
    s_branch L_row1

L_loop:
    s_sub_u32 s4, s4, 1
    s_cmp_eq_u32 s4, 0
    s_cselect_b32 s5, 0x40000000, 0
    s_or_b32 s5, s5, 16384
    s_mov_b32 s38, 16384
    v_add_u32 v46, 16384, v45
    s_waitcnt vmcnt(3)
    buffer_load_dwordx4 v[32:35], v46, s[12:15], 0 offen nt
    v_lshlrev_b32 v16, 16, v24
    v_and_b32 v17, s20, v24
    v_lshlrev_b32 v18, 16, v25
    v_and_b32 v19, s20, v25
    v_lshlrev_b32 v20, 16, v26
    v_and_b32 v21, s20, v26
    v_lshlrev_b32 v6, 16, v27
    v_and_b32 v7, s20, v27
    v_pk_mul_f32 v[48:49], v[16:17], v[16:17]
    v_pk_mul_f32 v[50:51], v[18:19], v[18:19]
    v_cvt_pk_bf16_f32 v24, v48, v49
    v_pk_mul_f32 v[48:49], v[20:21], v[20:21]
    v_cvt_pk_bf16_f32 v25, v50, v51
    v_pk_mul_f32 v[50:51], v[6:7], v[6:7]
    v_cvt_pk_bf16_f32 v26, v48, v49
    v_cvt_pk_bf16_f32 v27, v50, v51
    v_dot2_f32_bf16 v4, v24, s21, 0
    v_dot2_f32_bf16 v4, v25, s21, v4
    v_dot2_f32_bf16 v4, v26, s21, v4
    v_dot2_f32_bf16 v4, v27, s21, v4
    s_nop 2
    v_add_f32_dpp v4, v4, v4 quad_perm:[1,0,3,2] row_mask:0xf bank_mask:0xf
    s_nop 1
    v_add_f32_dpp v4, v4, v4 quad_perm:[2,3,0,1] row_mask:0xf bank_mask:0xf
    s_nop 1
    v_add_f32_dpp v4, v4, v4 row_half_mirror row_mask:0xf bank_mask:0xf
    s_nop 1
    v_add_f32_dpp v4, v4, v4 row_mirror row_mask:0xf bank_mask:0xf
    s_nop 1
    v_add_f32_dpp v4, v4, v4 row_bcast:15 row_mask:0xa bank_mask:0xf
    s_nop 1
    v_add_f32_dpp v4, v4, v4 row_bcast:31 row_mask:0xc bank_mask:0xf
    v_cvt_pk_bf16_f32 v4, 0, v4
    v_add_f32 v4, 0x35860000, v4
    v_cvt_pk_bf16_f32 v4, 0, v4
    v_sqrt_f32 v4, v4
    s_nop 0
    v_cvt_pk_bf16_f32 v4, 0, v4
    v_rcp_f32 v4, v4
    s_nop 0
    v_readlane_b32 s24, v4, 63
    s_nop 1
    v_pk_mul_f32 v[16:17], v[16:17], s[24:25] op_sel_hi:[1,0]
    v_pk_mul_f32 v[18:19], v[18:19], s[24:25] op_sel_hi:[1,0]
    v_pk_mul_f32 v[20:21], v[20:21], s[24:25] op_sel_hi:[1,0]
    v_pk_mul_f32 v[6:7], v[6:7], s[24:25] op_sel_hi:[1,0]
    v_pk_mul_f32 v[16:17], v[16:17], v[8:9]
    v_pk_mul_f32 v[18:19], v[18:19], v[10:11]
    v_pk_mul_f32 v[20:21], v[20:21], v[12:13]
    v_pk_mul_f32 v[6:7], v[6:7], v[14:15]
    v_cvt_pk_bf16_f32 v24, v16, v17
    v_cvt_pk_bf16_f32 v25, v18, v19
    v_cvt_pk_bf16_f32 v26, v20, v21
    v_cvt_pk_bf16_f32 v27, v6, v7
    buffer_store_dwordx4 v[24:27], v44, s[28:31], 0 offen sc1
    s_cmp_eq_u32 s6, 0
    s_cbranch_scc1 L_choose
L_row1:
    v_add_u32 v47, s38, v46
    s_waitcnt vmcnt(3)
    buffer_load_dwordx4 v[36:39], v47, s[12:15], 0 offen nt
    v_lshlrev_b32 v16, 16, v28
    v_and_b32 v17, s20, v28
    v_lshlrev_b32 v18, 16, v29
    v_and_b32 v19, s20, v29
    v_lshlrev_b32 v20, 16, v30
    v_and_b32 v21, s20, v30
    v_lshlrev_b32 v6, 16, v31
    v_and_b32 v7, s20, v31
    v_pk_mul_f32 v[48:49], v[16:17], v[16:17]
    v_pk_mul_f32 v[50:51], v[18:19], v[18:19]
    v_cvt_pk_bf16_f32 v28, v48, v49
    v_pk_mul_f32 v[48:49], v[20:21], v[20:21]
    v_cvt_pk_bf16_f32 v29, v50, v51
    v_pk_mul_f32 v[50:51], v[6:7], v[6:7]
    v_cvt_pk_bf16_f32 v30, v48, v49
    v_cvt_pk_bf16_f32 v31, v50, v51
    v_dot2_f32_bf16 v4, v28, s21, 0
    v_dot2_f32_bf16 v4, v29, s21, v4
    v_dot2_f32_bf16 v4, v30, s21, v4
    v_dot2_f32_bf16 v4, v31, s21, v4
    s_nop 2
    v_add_f32_dpp v4, v4, v4 quad_perm:[1,0,3,2] row_mask:0xf bank_mask:0xf
    s_nop 1
    v_add_f32_dpp v4, v4, v4 quad_perm:[2,3,0,1] row_mask:0xf bank_mask:0xf
    s_nop 1
    v_add_f32_dpp v4, v4, v4 row_half_mirror row_mask:0xf bank_mask:0xf
    s_nop 1
    v_add_f32_dpp v4, v4, v4 row_mirror row_mask:0xf bank_mask:0xf
    s_nop 1
    v_add_f32_dpp v4, v4, v4 row_bcast:15 row_mask:0xa bank_mask:0xf
    s_nop 1
    v_add_f32_dpp v4, v4, v4 row_bcast:31 row_mask:0xc bank_mask:0xf
    v_cvt_pk_bf16_f32 v4, 0, v4
    v_add_f32 v4, 0x35860000, v4
    v_cvt_pk_bf16_f32 v4, 0, v4
    v_sqrt_f32 v4, v4
    s_nop 0
    v_cvt_pk_bf16_f32 v4, 0, v4
    v_rcp_f32 v4, v4
    s_nop 0
    v_readlane_b32 s24, v4, 63
    s_nop 1
    v_pk_mul_f32 v[16:17], v[16:17], s[24:25] op_sel_hi:[1,0]
    v_pk_mul_f32 v[18:19], v[18:19], s[24:25] op_sel_hi:[1,0]
    v_pk_mul_f32 v[20:21], v[20:21], s[24:25] op_sel_hi:[1,0]
    v_pk_mul_f32 v[6:7], v[6:7], s[24:25] op_sel_hi:[1,0]
    v_pk_mul_f32 v[16:17], v[16:17], v[8:9]
    v_pk_mul_f32 v[18:19], v[18:19], v[10:11]
    v_pk_mul_f32 v[20:21], v[20:21], v[12:13]
    v_pk_mul_f32 v[6:7], v[6:7], v[14:15]
    v_cvt_pk_bf16_f32 v28, v16, v17
    v_cvt_pk_bf16_f32 v29, v18, v19
    v_cvt_pk_bf16_f32 v30, v20, v21
    v_cvt_pk_bf16_f32 v31, v6, v7
    buffer_store_dwordx4 v[28:31], v45, s[28:31], 0 offen sc1
    v_add_u32 v44, s5, v47
    s_waitcnt vmcnt(3)
    buffer_load_dwordx4 v[24:27], v44, s[12:15], 0 offen nt
    v_lshlrev_b32 v16, 16, v32
    v_and_b32 v17, s20, v32
    v_lshlrev_b32 v18, 16, v33
    v_and_b32 v19, s20, v33
    v_lshlrev_b32 v20, 16, v34
    v_and_b32 v21, s20, v34
    v_lshlrev_b32 v6, 16, v35
    v_and_b32 v7, s20, v35
    v_pk_mul_f32 v[48:49], v[16:17], v[16:17]
    v_pk_mul_f32 v[50:51], v[18:19], v[18:19]
    v_cvt_pk_bf16_f32 v32, v48, v49
    v_pk_mul_f32 v[48:49], v[20:21], v[20:21]
    v_cvt_pk_bf16_f32 v33, v50, v51
    v_pk_mul_f32 v[50:51], v[6:7], v[6:7]
    v_cvt_pk_bf16_f32 v34, v48, v49
    v_cvt_pk_bf16_f32 v35, v50, v51
    v_dot2_f32_bf16 v4, v32, s21, 0
    v_dot2_f32_bf16 v4, v33, s21, v4
    v_dot2_f32_bf16 v4, v34, s21, v4
    v_dot2_f32_bf16 v4, v35, s21, v4
    s_nop 2
    v_add_f32_dpp v4, v4, v4 quad_perm:[1,0,3,2] row_mask:0xf bank_mask:0xf
    s_nop 1
    v_add_f32_dpp v4, v4, v4 quad_perm:[2,3,0,1] row_mask:0xf bank_mask:0xf
    s_nop 1
    v_add_f32_dpp v4, v4, v4 row_half_mirror row_mask:0xf bank_mask:0xf
    s_nop 1
    v_add_f32_dpp v4, v4, v4 row_mirror row_mask:0xf bank_mask:0xf
    s_nop 1
    v_add_f32_dpp v4, v4, v4 row_bcast:15 row_mask:0xa bank_mask:0xf
    s_nop 1
    v_add_f32_dpp v4, v4, v4 row_bcast:31 row_mask:0xc bank_mask:0xf
    v_cvt_pk_bf16_f32 v4, 0, v4
    v_add_f32 v4, 0x35860000, v4
    v_cvt_pk_bf16_f32 v4, 0, v4
    v_sqrt_f32 v4, v4
    s_nop 0
    v_cvt_pk_bf16_f32 v4, 0, v4
    v_rcp_f32 v4, v4
    s_nop 0
    v_readlane_b32 s24, v4, 63
    s_nop 1
    v_pk_mul_f32 v[16:17], v[16:17], s[24:25] op_sel_hi:[1,0]
    v_pk_mul_f32 v[18:19], v[18:19], s[24:25] op_sel_hi:[1,0]
    v_pk_mul_f32 v[20:21], v[20:21], s[24:25] op_sel_hi:[1,0]
    v_pk_mul_f32 v[6:7], v[6:7], s[24:25] op_sel_hi:[1,0]
    v_pk_mul_f32 v[16:17], v[16:17], v[8:9]
    v_pk_mul_f32 v[18:19], v[18:19], v[10:11]
    v_pk_mul_f32 v[20:21], v[20:21], v[12:13]
    v_pk_mul_f32 v[6:7], v[6:7], v[14:15]
    v_cvt_pk_bf16_f32 v32, v16, v17
    v_cvt_pk_bf16_f32 v33, v18, v19
    v_cvt_pk_bf16_f32 v34, v20, v21
    v_cvt_pk_bf16_f32 v35, v6, v7
    s_cmp_eq_u32 s4, 0
    s_cbranch_scc1 L_last2
    buffer_store_dwordx4 v[32:35], v46, s[28:31], 0 offen sc1
    s_branch L_row3
L_last2:
    s_load_dword s27, s[10:11], 128
    buffer_store_dwordx4 v[32:35], v46, s[28:31], 0 offen
L_row3:
    v_add_u32 v45, s5, v44
    s_waitcnt vmcnt(3)
    buffer_load_dwordx4 v[28:31], v45, s[12:15], 0 offen nt
    v_lshlrev_b32 v16, 16, v36
    v_and_b32 v17, s20, v36
    v_lshlrev_b32 v18, 16, v37
    v_and_b32 v19, s20, v37
    v_lshlrev_b32 v20, 16, v38
    v_and_b32 v21, s20, v38
    v_lshlrev_b32 v6, 16, v39
    v_and_b32 v7, s20, v39
    v_pk_mul_f32 v[48:49], v[16:17], v[16:17]
    v_pk_mul_f32 v[50:51], v[18:19], v[18:19]
    v_cvt_pk_bf16_f32 v36, v48, v49
    v_pk_mul_f32 v[48:49], v[20:21], v[20:21]
    v_cvt_pk_bf16_f32 v37, v50, v51
    v_pk_mul_f32 v[50:51], v[6:7], v[6:7]
    v_cvt_pk_bf16_f32 v38, v48, v49
    v_cvt_pk_bf16_f32 v39, v50, v51
    v_dot2_f32_bf16 v4, v36, s21, 0
    v_dot2_f32_bf16 v4, v37, s21, v4
    v_dot2_f32_bf16 v4, v38, s21, v4
    v_dot2_f32_bf16 v4, v39, s21, v4
    s_nop 2
    v_add_f32_dpp v4, v4, v4 quad_perm:[1,0,3,2] row_mask:0xf bank_mask:0xf
    s_nop 1
    v_add_f32_dpp v4, v4, v4 quad_perm:[2,3,0,1] row_mask:0xf bank_mask:0xf
    s_nop 1
    v_add_f32_dpp v4, v4, v4 row_half_mirror row_mask:0xf bank_mask:0xf
    s_nop 1
    v_add_f32_dpp v4, v4, v4 row_mirror row_mask:0xf bank_mask:0xf
    s_nop 1
    v_add_f32_dpp v4, v4, v4 row_bcast:15 row_mask:0xa bank_mask:0xf
    s_nop 1
    v_add_f32_dpp v4, v4, v4 row_bcast:31 row_mask:0xc bank_mask:0xf
    v_cvt_pk_bf16_f32 v4, 0, v4
    v_add_f32 v4, 0x35860000, v4
    v_cvt_pk_bf16_f32 v4, 0, v4
    v_sqrt_f32 v4, v4
    s_nop 0
    v_cvt_pk_bf16_f32 v4, 0, v4
    v_rcp_f32 v4, v4
    s_nop 0
    v_readlane_b32 s24, v4, 63
    s_nop 1
    v_pk_mul_f32 v[16:17], v[16:17], s[24:25] op_sel_hi:[1,0]
    v_pk_mul_f32 v[18:19], v[18:19], s[24:25] op_sel_hi:[1,0]
    v_pk_mul_f32 v[20:21], v[20:21], s[24:25] op_sel_hi:[1,0]
    v_pk_mul_f32 v[6:7], v[6:7], s[24:25] op_sel_hi:[1,0]
    v_pk_mul_f32 v[16:17], v[16:17], v[8:9]
    v_pk_mul_f32 v[18:19], v[18:19], v[10:11]
    v_pk_mul_f32 v[20:21], v[20:21], v[12:13]
    v_pk_mul_f32 v[6:7], v[6:7], v[14:15]
    v_cvt_pk_bf16_f32 v36, v16, v17
    v_cvt_pk_bf16_f32 v37, v18, v19
    v_cvt_pk_bf16_f32 v38, v20, v21
    v_cvt_pk_bf16_f32 v39, v6, v7
    s_cmp_eq_u32 s4, 0
    s_cbranch_scc1 L_last3
    buffer_store_dwordx4 v[36:39], v47, s[28:31], 0 offen sc1
    s_branch L_loop
L_last3:
    buffer_store_dwordx4 v[36:39], v47, s[28:31], 0 offen
    s_waitcnt lgkmcnt(0)
    s_cmp_eq_u32 s27, s26
    s_cbranch_scc0 L_check
L_done:
    s_endpgm

L_fixed:
    s_waitcnt lgkmcnt(0)
    s_mov_b32 s26, 0
    s_mov_b32 s6, 2
    s_branch L_row1
L_publish:
    s_mov_b64 exec, 1
    v_mov_b32 v20, 128
    v_mov_b32 v21, s26
    global_store_byte v20, v21, s[10:11] sc0 sc1
    s_mov_b64 exec, -1
    s_branch L_chosen
L_poll0:
    v_lshrrev_b32 v20, 4, v1
    v_add_u32 v20, s45, v20
    s_mov_b64 exec, 0x10000
    v_mov_b32 v20, 128
L_poll:
    s_mov_b64 exec, 0x1ffff
    global_load_ubyte v21, v20, s[10:11] sc1
    s_add_u32 s49, s49, 1
    s_waitcnt vmcnt(0)
    v_readlane_b32 s26, v21, 16
    v_cmp_eq_u32 vcc, 1, v21
    v_cmp_eq_u32 s[58:59], 2, v21
    s_mov_b64 exec, -1
    s_cmp_lg_u32 s26, 0
    s_cbranch_scc1 L_chosen
    s_bcnt1_i32_b64 s44, vcc
    s_bcnt1_i32_b64 s58, s[58:59]
    s_absdiff_i32 s59, s58, s44
    s_cmp_ge_u32 s59, 6
    s_cbranch_scc1 L_majority
    s_add_u32 s59, s58, s44
    s_lshr_b32 s59, s59, 4
    s_cmp_gt_u32 s59, s8
    s_cbranch_scc1 L_majority
    s_cmp_lt_u32 s49, 40
    s_cbranch_scc1 L_poll
    s_branch L_majority
L_check:
    s_cmp_eq_u32 s6, 2
    s_cbranch_scc1 L_done
    v_mov_b32 v20, 128
    global_load_ubyte v21, v20, s[10:11] sc0 sc1
    s_waitcnt vmcnt(0)
    v_readfirstlane_b32 s27, v21
    s_nop 1
    s_cmp_eq_u32 s27, s26
    s_cbranch_scc1 L_done
    s_xor_b32 s26, s26, 3
    s_mov_b32 s6, 2
    s_mov_b32 s4, 4
    v_xor_b32 v44, 0x2000, v47
    v_subrev_u32 v44, 245760, v44
    v_add_u32 v45, 16384, v44
    buffer_load_dwordx4 v[24:27], v44, s[12:15], 0 offen nt
    buffer_load_dwordx4 v[28:31], v45, s[12:15], 0 offen nt
    s_waitcnt vmcnt(0)
    s_branch L_loop
.section .rodata,"a"
.p2align 6
.amdhsa_kernel standalone__rmsnorm__sampling_kernel
  .amdhsa_next_free_vgpr 52
  .amdhsa_next_free_sgpr 60
  .amdhsa_accum_offset 52
  .amdhsa_group_segment_fixed_size 0
  .amdhsa_kernarg_size 40
  .amdhsa_user_sgpr_count 2
  .amdhsa_user_sgpr_kernarg_segment_ptr 1
  .amdhsa_system_sgpr_workgroup_id_x 1
  .amdhsa_float_denorm_mode_32 3
.end_amdhsa_kernel
```
